```python
import torch

def _softmax(x, axis=-1):
    return torch.softmax(x, dim=axis)
def _gelu(x):
    return torch.nn.functional.gelu(x, approximate="tanh")
def _silu(x):
    return torch.nn.functional.silu(x)
def _sigmoid(x):
    return torch.sigmoid(x)
def _layernorm(x, axis=-1, eps=1e-5):
    m = x.mean(dim=axis, keepdim=True)
    v = x.var(dim=axis, keepdim=True, unbiased=False)
    return (x - m) / torch.sqrt(v + eps)
def _scatter_add(tgt, idx, src, axis=0):
    return tgt.clone().index_add_(axis, idx, src)
def _segment_sum(src, seg, n):
    out = torch.zeros((n,) + src.shape[1:], dtype=src.dtype)
    return out.index_add_(0, seg, src)
def _pad(x, pw):
    flat = tuple(v for pair in reversed(pw) for v in pair)
    return torch.nn.functional.pad(x, flat)

kernel_name = 'recurrent_scan__sliding_block_cached__glu_gated_reglu__decode'

def setup_inputs():

    _w = (lambda a: (lambda t: t.to(torch.bfloat16) if t.is_floating_point() else t)(torch.as_tensor(a)))
    def _A_setup():
        B, Sq, D = 4, 1, 448
        Hq, Hkv, Sk, Dh = 16, 8, 4096, 256
        assert Hq % Hkv == 0, (Hq, Hkv)
        return {
            "x": _w((lambda *s: torch.randn(*s, dtype=torch.bfloat16) * 0.05)(B, Sq, D)),
            "k_cache": _w((lambda *s: torch.randn(*s, dtype=torch.bfloat16) * 1.6)(B, Hkv, Sk, Dh)),
            "v_cache": _w((lambda *s: torch.randn(*s, dtype=torch.bfloat16) * 1.6)(B, Hkv, Sk, Dh)),
            "wq": _w((lambda *s: torch.randn(*s, dtype=torch.bfloat16) * 1.6)(D, Hq * Dh) * (D ** -0.5)),
            "wo": _w((lambda *s: torch.randn(*s, dtype=torch.bfloat16) * 1.6)(Hq * Dh, D) * ((Hq * Dh) ** -0.5)),
        }
    _A_in = _A_setup()

    def _B_setup():
        B, S, D, F = 4, 1, 448, 1792
        return {
            "x": _w((lambda *s: torch.randn(*s, dtype=torch.bfloat16) * 0.05)(B, S, D)),
            "W_gate": _w((lambda *s: torch.randn(*s, dtype=torch.bfloat16) * 0.2)(D, F) * (2.0 / D) ** 0.5),
            "W_up": _w((lambda *s: torch.randn(*s, dtype=torch.bfloat16) * 0.2)(D, F) * (2.0 / D) ** 0.5),
            "W_down": _w((lambda *s: torch.randn(*s, dtype=torch.bfloat16) * 0.2)(F, D) * (1.0 / F) ** 0.5),
        }
    _B_in = _B_setup()

    return {
        "A_x": _A_in["x"],
        "A_k_cache": _A_in["k_cache"],
        "A_v_cache": _A_in["v_cache"],
        "A_wq": _A_in["wq"],
        "A_wo": _A_in["wo"],
        "B_x": _B_in["x"],
        "B_W_gate": _B_in["W_gate"],
        "B_W_up": _B_in["W_up"],
        "B_W_down": _B_in["W_down"],
    }

def reference(A_x, A_k_cache, A_v_cache, A_wq, A_wo, B_x, B_W_gate, B_W_up, B_W_down):
    def _A_ref(x, k_cache, v_cache, wq, wo):
        B, Sq, D = x.shape
        Hq, Dh = 16, 256
        Hkv, Sk = k_cache.shape[1], k_cache.shape[2]
        W = min(4096, max(256, Sk // 4))
        rep = Hq // Hkv
        q = (lambda x, *d: x.permute(*d))((x @ wq).reshape(B, Sq, Hq, Dh), 0, 2, 1, 3)
        k = (lambda x, n, axis: torch.repeat_interleave(x, n, dim=axis))(k_cache[:, :, Sk - W:, :], rep, axis=1)
        v = (lambda x, n, axis: torch.repeat_interleave(x, n, dim=axis))(v_cache[:, :, Sk - W:, :], rep, axis=1)
        scores = torch.einsum("bhqd,bhkd->bhqk", q, k) * (Dh ** -0.5)
        p = _softmax(scores, axis=-1)
        o = torch.einsum("bhqk,bhkd->bhqd", p, v)
        return (lambda x, *d: x.permute(*d))(o, 0, 2, 1, 3).reshape(B, Sq, Hq * Dh) @ wo

    def _B_ref(x, W_gate, W_up, W_down):
        gate = torch.einsum("bsd,df->bsf", x, W_gate)
        up = torch.einsum("bsd,df->bsf", x, W_up)
        gate = gate * (lambda x, dt: x.to(dt))(gate > 0, gate.dtype)
        h = gate * up
        return torch.einsum("bsf,fd->bsd", h, W_down)

    x = A_x
    xn = _layernorm(x, axis=-1)
    s = _A_ref(xn, A_k_cache, A_v_cache, A_wq, A_wo)
    g = _silu(_B_ref(xn, B_W_gate, B_W_up, B_W_down))
    return x + s * g
```

```asm
; @launch grid=(256,1,1) block=(640,1,1) lds=137728
.amdgcn_target "amdgcn-amd-amdhsa--gfx950"
.text
.globl recurrent_scan__sliding_block_cached__glu_gated_reglu__decode_kernel
.p2align 8
.type recurrent_scan__sliding_block_cached__glu_gated_reglu__decode_kernel,@function
recurrent_scan__sliding_block_cached__glu_gated_reglu__decode_kernel:
    s_cmp_ge_u32 s2, 256
    s_cbranch_scc1 L_exit
    s_load_dwordx16 s[16:31], s[0:1], 0
    s_load_dwordx8 s[32:39], s[0:1], 64
    s_memrealtime s[70:71]
    s_and_b32 s40, s2, 7
    s_lshr_b32 s42, s2, 6
    s_bfe_u32 s43, s2, 0x30003
    v_lshrrev_b32 v11, 3, v0
    v_and_b32 v9, 6, v11
    v_xor_b32 v9, v9, v0
    v_and_b32 v9, 7, v9
    v_lshlrev_b32 v9, 4, v9
    v_cmp_gt_u32 vcc, 64, v0
    s_cbranch_vccnz L_strike
    v_cmp_gt_u32 vcc, 0x80, v0
    s_cbranch_vccz L_clear
    s_getpc_b64 s[4:5]
L_pc:
    s_bfe_u32 s6, s2, 0x20003
    s_lshl_b32 s6, s6, 12
    v_and_b32 v2, 31, v0
    v_lshl_add_u32 v2, v2, 7, s6
    v_min_u32 v2, L_codeend-L_pc-4, v2
    global_load_dword v3, v2, s[4:5]
L_clear:
    v_and_b32 v2, 63, v0
    v_lshlrev_b32 v2, 2, v2
    v_add_u32 v2, 137472, v2
    v_mov_b32 v4, 0
    ds_write_b32 v2, v4
    s_branch L_decode
L_strike:
    v_lshl_add_u32 v12, v11, 9, v9
    s_lshl3_add_u32 s68, s42, s40
    s_lshl4_add_u32 s68, s68, 12
    s_lshl1_add_u32 s68, s68, s43
    s_lshl_b32 s68, s68, 16
    s_mul_i32 s66, s2, 0x9e37
    s_and_b32 s13, s66, 0xf000
    s_lshl_b32 s66, s66, 5
    s_and_b32 s66, s66, 0xe000
    s_add_u32 s66, s66, 4096
    s_mov_b32 s65, s13
    s_mov_b32 s54, 0x4000000
    s_mov_b32 s55, 0x20000
    s_mov_b32 m0, 0
    s_waitcnt lgkmcnt(0)
    s_mov_b32 s52, s18
    s_mov_b32 s53, s19
L_strike_loop:
    s_add_u32 s62, s68, s65
    buffer_load_dwordx4 v12, s[52:55], s62 offen nt lds
    s_add_u32 m0, m0, 896
    s_add_u32 s65, s65, s66
    buffer_load_dwordx4 v12, s[52:55], s62 offen offset:128 nt lds
    s_add_u32 m0, m0, 896
    s_and_b32 s65, s65, 0xffff
    buffer_load_dwordx4 v12, s[52:55], s62 offen offset:256 nt lds
    s_add_u32 m0, m0, 896
    s_nop 0
    buffer_load_dwordx4 v12, s[52:55], s62 offen offset:384 nt lds
    s_add_u32 m0, m0, 1408
    s_cmp_lt_u32 m0, 12288
    s_cbranch_scc1 L_strike_loop
L_decode:
    v_lshrrev_b32 v4, 6, v0
    s_lshr_b32 s6, s2, 5
    s_and_b32 s61, s2, 31
    v_readfirstlane_b32 s3, v4
    s_lshr_b32 s41, s2, 3
    s_lshl3_add_u32 s7, s40, s43
    s_cmp_lt_u32 s61, 28
    s_cselect_b32 s69, s6, 7
    s_cmp_lt_u32 s6, 4
    s_cselect_b32 s69, s6, s69
    s_cselect_b32 s61, s7, s61
    s_lshl_b32 s6, s69, 2
    s_or_b32 s6, s6, 0x40000
    s_bfe_u32 s60, 0x03112211, s6
    s_bfe_u32 s64, 0x08778877, s6
    s_lshl_b32 s64, s64, 1
    v_mov_b32 v1, 137472
    s_cmp_eq_u32 s3, 0
    s_cbranch_scc0 L_others
    s_bfe_u32 s7, 0x18764433, s6
    s_lshl_b32 s7, s7, 3
    s_load_dwordx2 s[52:53], s[0:1], s7
    s_setprio 2
    s_mov_b32 s4, 3
    s_mov_b32 s5, 0
    s_mov_b32 s7, 0
    s_mov_b32 s67, 3
    s_add_u32 s47, s64, 3
    s_mov_b32 s63, 0
    s_mov_b32 s44, -1
    s_mov_b32 s55, 0x20000
    s_mov_b32 m0, 65536
    s_movk_i32 s57, 2000
    s_mov_b32 s59, s57
    s_cmp_eq_u32 s60, 1
    s_cbranch_scc0 L_ld_notp
    s_movk_i32 s56, 197
    s_movk_i32 s45, 3584
    s_cmp_lt_u32 s69, 2
    s_cselect_b32 s45, 8192, s45
    s_cselect_b32 s57, -30000, s57
    s_cselect_b32 s59, 264, s59
    s_cselect_b32 s56, 248, s56
    s_mul_i32 s54, s45, 448
    v_mad_u32_u24 v12, s45, v11, v9
    s_lshl_b32 s6, s45, 3
    s_lshl_b32 s45, s45, 5
    s_movk_i32 s9, 1024
    s_lshl_b32 s46, s61, 7
    s_branch L_ld_first
L_ld_notp:
    s_cmp_eq_u32 s60, 0
    s_cbranch_scc1 L_ld_none
    s_movk_i32 s56, 188
    s_mov_b32 s54, 1605632
    s_cmp_eq_u32 s60, 2
    s_cselect_b32 s54, 3670016, s54
    s_cselect_b32 s56, 188, s56
    s_mul_i32 s46, s61, 57344
    v_lshlrev_b32 v12, 4, v0
    s_movk_i32 s6, 896
    s_movk_i32 s45, 3584
    s_movk_i32 s9, 928
    s_mov_b32 exec_hi, 0x00ffffff
L_ld_first:
    s_waitcnt lgkmcnt(0)
    s_barrier
L_ld_go:
    v_add_u32 v13, s6, v12
    v_add_u32 v14, s6, v13
    v_add_u32 v15, s6, v14
L_ld_loop:
    s_add_u32 s62, s46, s63
    buffer_load_dwordx4 v12, s[52:55], s62 offen nt lds
    s_add_u32 m0, m0, s9
    s_memrealtime s[10:11]
    buffer_load_dwordx4 v13, s[52:55], s62 offen nt lds
    s_add_u32 m0, m0, s9
    ds_read_b32 v3, v1 offset:32
    buffer_load_dwordx4 v14, s[52:55], s62 offen nt lds
    s_add_u32 m0, m0, s9
    s_mul_i32 s58, s7, s56
    buffer_load_dwordx4 v15, s[52:55], s62 offen nt lds
    s_add_u32 m0, m0, s9
    s_add_u32 s58, s58, s57
    s_add_u32 s4, s4, 1
    s_add_u32 s46, s46, s45
    s_and_b32 s46, s46, s44
    s_waitcnt lgkmcnt(0)
    v_readfirstlane_b32 s11, v3
    s_sub_u32 s10, s10, s70
    s_sub_u32 s10, s10, s11
    s_lshl_b32 s10, s10, 4
    s_sub_u32 s10, s10, s58
    s_add_u32 s10, s10, 511
    s_ashr_i32 s10, s10, 9
    s_min_i32 s10, s10, 4
    s_lshl_b32 s8, s10, 1
    s_add_u32 s8, s8, 3
    s_cmp_gt_i32 s10, 0
    s_cselect_b32 s8, s8, s67
    s_sub_u32 s10, s4, s8
    s_max_i32 s7, s7, s10
    v_mov_b32 v2, s7
    s_waitcnt vmcnt(44)
    s_cmp_ge_u32 s8, 11
    s_cbranch_scc1 L_ld_paced
    s_waitcnt vmcnt(36)
    s_cmp_ge_u32 s8, 9
    s_cbranch_scc1 L_ld_paced
    s_waitcnt vmcnt(28)
    s_cmp_ge_u32 s8, 7
    s_cbranch_scc1 L_ld_paced
    s_waitcnt vmcnt(20)
    s_cmp_ge_u32 s8, 5
    s_cbranch_scc1 L_ld_paced
    s_waitcnt vmcnt(12)
    s_cmp_ge_u32 s8, 3
    s_cbranch_scc1 L_ld_paced
    s_waitcnt vmcnt(8)
L_ld_paced:
    ds_write_b32 v1, v2 offset:8
    s_cmp_lt_u32 s4, s47
    s_cbranch_scc1 L_ld_loop
    s_mov_b64 exec, -1
    s_cmp_eq_u32 s5, 1
    s_cbranch_scc1 L_ld_v
    s_cmp_gt_u32 s5, 1
    s_cbranch_scc1 L_drain
    s_mov_b32 s52, s18
    s_mov_b32 s53, s19
    s_mov_b32 s5, 1
    s_mov_b32 s57, s59
    s_mov_b32 s54, 0x4000000
    v_lshl_add_u32 v12, v11, 9, v9
    s_mov_b32 s63, s68
    s_mov_b32 s46, s65
    s_mov_b32 s44, 0xffff
    s_movk_i32 s6, 128
    s_mov_b32 s45, s66
    s_movk_i32 s9, 1024
    s_add_u32 s47, s64, 16
    s_mov_b32 m0, 12288
    s_branch L_ld_go
L_ld_none:
    s_movk_i32 s56, 310
    s_mov_b32 s67, 2
    s_mov_b32 s5, 1
    s_mov_b32 s57, s59
    s_mov_b32 s54, 0x4000000
    v_lshl_add_u32 v12, v11, 9, v9
    s_mov_b32 s63, s68
    s_mov_b32 s46, s65
    s_mov_b32 s44, 0xffff
    s_movk_i32 s6, 128
    s_mov_b32 s45, s66
    s_movk_i32 s9, 1024
    s_add_u32 s47, s64, 16
    s_mov_b32 m0, 12288
    s_branch L_ld_first
L_ld_v:
    s_mov_b32 s5, 2
    s_mov_b32 s52, s20
    s_mov_b32 s53, s21
    s_mov_b32 s46, s13
    s_add_u32 s47, s64, 32
    s_cmp_lg_u32 s64, 0
    s_cselect_b32 s6, 7, 0
    s_cmp_eq_u32 s60, 1
    s_cselect_b32 s6, 4, s6
    s_mov_b32 s12, 0x40000
L_lw_1:
    ds_read_b32 v2, v1 offset:16
    s_waitcnt lgkmcnt(0)
    v_cmp_le_i32 vcc, s6, v2
    s_cbranch_vccnz L_lwd_2
    s_sub_u32 s12, s12, 1
    s_cbranch_scc0 L_lw_1
L_lwd_2:
    s_mov_b32 m0, 65536
    s_branch L_ld_loop
L_drain:
    s_sub_u32 s6, s4, 10
    s_max_i32 s6, s6, s7
    v_mov_b32 v2, s6
    s_waitcnt vmcnt(40)
    ds_write_b32 v1, v2 offset:8
    s_sub_u32 s6, s4, 9
    s_max_i32 s6, s6, s7
    v_mov_b32 v2, s6
    s_waitcnt vmcnt(36)
    ds_write_b32 v1, v2 offset:8
    s_sub_u32 s6, s4, 8
    s_max_i32 s6, s6, s7
    v_mov_b32 v2, s6
    s_waitcnt vmcnt(32)
    ds_write_b32 v1, v2 offset:8
    s_sub_u32 s6, s4, 7
    s_max_i32 s6, s6, s7
    v_mov_b32 v2, s6
    s_waitcnt vmcnt(28)
    ds_write_b32 v1, v2 offset:8
    s_sub_u32 s6, s4, 6
    s_max_i32 s6, s6, s7
    v_mov_b32 v2, s6
    s_waitcnt vmcnt(24)
    ds_write_b32 v1, v2 offset:8
    s_sub_u32 s6, s4, 5
    s_max_i32 s6, s6, s7
    v_mov_b32 v2, s6
    s_waitcnt vmcnt(20)
    ds_write_b32 v1, v2 offset:8
    s_sub_u32 s6, s4, 4
    s_max_i32 s6, s6, s7
    v_mov_b32 v2, s6
    s_waitcnt vmcnt(16)
    ds_write_b32 v1, v2 offset:8
    s_sub_u32 s6, s4, 3
    s_max_i32 s6, s6, s7
    v_mov_b32 v2, s6
    s_waitcnt vmcnt(12)
    ds_write_b32 v1, v2 offset:8
    s_sub_u32 s6, s4, 2
    s_max_i32 s6, s6, s7
    v_mov_b32 v2, s6
    s_waitcnt vmcnt(8)
    ds_write_b32 v1, v2 offset:8
    s_sub_u32 s6, s4, 1
    s_max_i32 s6, s6, s7
    v_mov_b32 v2, s6
    s_waitcnt vmcnt(4)
    ds_write_b32 v1, v2 offset:8
    s_sub_u32 s6, s4, 0
    s_max_i32 s6, s6, s7
    v_mov_b32 v2, s6
    s_waitcnt vmcnt(0)
    ds_write_b32 v1, v2 offset:8
    s_endpgm
L_others:
    v_and_b32 v0, 63, v0
    v_lshrrev_b32 v5, 4, v0
    v_and_b32 v6, 15, v0
    v_bfe_u32 v7, v0, 2, 2
    v_and_b32 v8, 3, v0
    s_sub_u32 s3, s3, 2
    s_cmp_eq_u32 s69, 4
    s_cselect_b32 s6, 64, 0
    s_cmp_eq_u32 s69, 5
    s_cselect_b32 s6, 92, s6
    s_add_u32 s61, s61, s6
    s_waitcnt lgkmcnt(0)
    s_load_dword s14, s[38:39], 0
    s_mov_b32 s48, s38
    s_mov_b32 s49, s39
    s_mov_b32 s50, 4194304
    s_mov_b32 s51, 0x20000
    s_cmp_eq_u32 s3, -1
    s_cbranch_scc1 L_helper
    s_barrier
    s_waitcnt lgkmcnt(0)
    s_mul_i32 s15, s14, 0x9E3779B1
    s_add_u32 s15, s15, 0x632BE5AB
    v_lshl_add_u32 v9, v5, 2, v7
    v_bfe_u32 v10, v9, 1, 2
    v_mov_b32 v102, 0
    s_mov_b32 s4, 0x07060500
    s_mov_b32 s5, 0x07060501
    s_mov_b32 s6, 0x07060502
    s_mov_b32 s7, 0x07060503
    s_movk_i32 s20, 0xff
    s_and_b32 s16, s15, s20
    s_bfe_u32 s17, s15, 0x80008
    s_bfe_u32 s18, s15, 0x80010
    s_lshr_b32 s19, s15, 24
    s_cmp_eq_u32 s60, 1
    s_cbranch_scc1 L_pjob
    s_cmp_eq_u32 s60, 0
    s_cbranch_scc1 L_k
    v_mul_u32_u24 v100, 928, v9
    v_lshl_add_u32 v100, v8, 3, v100
    s_lshl_b32 s46, s3, 7
    v_add_u32 v100, s46, v100
    v_add_u32 v11, 65536, v100
    v_mul_u32_u24 v101, 144, v7
    v_lshl_add_u32 v101, v5, 4, v101
    v_add_u32 v101, 136896, v101
    v_mul_u32_u24 v102, 28, v5
    v_and_b32 v103, 1, v7
    v_lshl_add_u32 v102, v103, 1, v102
    v_lshrrev_b32 v103, 1, v7
    v_add_u32 v102, v102, v103
    v_lshlrev_b32 v102, 12, v102
    v_lshl_add_u32 v102, v8, 4, v102
    v_mov_b32 v103, s15
    s_lshl_b32 s46, s3, 14
    s_lshl_b32 s47, s61, 6
    s_add_u32 s59, s46, s47
    s_cmp_eq_u32 s60, 3
    s_cselect_b32 s46, 524288, 0
    s_add_u32 s59, s59, s46
    s_add_u32 s59, s59, 2097152
    s_cmp_eq_u32 s3, 7
    s_cbranch_scc1 L_k
    s_mov_b32 s12, 0x40000
L_lw_3:
    ds_read_b32 v2, v1 offset:8
    s_waitcnt lgkmcnt(0)
    v_cmp_le_i32 vcc, 11, v2
    s_cbranch_vccnz L_lwd_4
    s_sleep 1
    s_sub_u32 s12, s12, 1
    s_cbranch_scc0 L_lw_3
L_lwd_4:
    ds_read_b64_tr_b16 v[104:105], v11 offset:0
    ds_read_b64_tr_b16 v[106:107], v11 offset:14848
    ds_read_b64_tr_b16 v[108:109], v11 offset:32
    ds_read_b64_tr_b16 v[110:111], v11 offset:14880
    ds_read_b64_tr_b16 v[112:113], v11 offset:64
    ds_read_b64_tr_b16 v[114:115], v11 offset:14912
    ds_read_b64_tr_b16 v[116:117], v11 offset:96
    ds_read_b64_tr_b16 v[118:119], v11 offset:14944
    s_mov_b32 s12, 0x40000
L_lw_5:
    ds_read_b32 v2, v1 offset:8
    s_waitcnt lgkmcnt(0)
    v_cmp_le_i32 vcc, 19, v2
    s_cbranch_vccnz L_lwd_6
    s_sleep 1
    s_sub_u32 s12, s12, 1
    s_cbranch_scc0 L_lw_5
L_lwd_6:
    ds_read_b64_tr_b16 v[120:121], v11 offset:29696
    ds_read_b64_tr_b16 v[122:123], v11 offset:44544
    ds_read_b64_tr_b16 v[124:125], v11 offset:29728
    ds_read_b64_tr_b16 v[126:127], v11 offset:44576
    ds_read_b64_tr_b16 v[128:129], v11 offset:29760
    ds_read_b64_tr_b16 v[130:131], v11 offset:44608
    ds_read_b64_tr_b16 v[132:133], v11 offset:29792
    ds_read_b64_tr_b16 v[134:135], v11 offset:44640
    s_waitcnt lgkmcnt(0)
    s_mov_b64 exec, 1
    v_mov_b32 v2, 1
    ds_add_u32 v1, v2 offset:16
    s_mov_b64 exec, -1
    s_branch L_k
L_pjob:
    s_cmp_lt_u32 s3, 4
    s_cbranch_scc0 L_k
    v_mul_u32_u24 v11, 912, v7
    v_lshl_add_u32 v11, v5, 4, v11
    v_add_u32 v11, 131072, v11
    v_lshlrev_b32 v12, 7, v9
    v_xor_b32 v13, s3, v10
    v_lshl_add_u32 v12, v13, 5, v12
    v_lshl_add_u32 v12, v8, 3, v12
    v_add_u32 v12, 65536, v12
    v_mul_u32_u24 v13, 30720, v5
    v_lshrrev_b32 v14, 1, v6
    v_lshl_add_u32 v13, v14, 3, v13
    s_lshl_b32 s45, s61, 8
    s_lshl_b32 s46, s3, 6
    s_add_u32 s45, s45, s46
    s_add_u32 s46, s45, 262144
    s_add_u32 s45, s45, 4096
    v_mov_b32 v15, s15
    s_mov_b32 s12, 0x40000
L_lw_7:
    ds_read_b32 v2, v1 offset:0
    s_waitcnt lgkmcnt(0)
    v_cmp_le_i32 vcc, 1, v2
    s_cbranch_vccnz L_lwd_8
    s_sleep 1
    s_sub_u32 s12, s12, 1
    s_cbranch_scc0 L_lw_7
L_lwd_8:
    ds_read_b128 v[48:51], v11 offset:0
    ds_read_b128 v[52:55], v11 offset:64
    ds_read_b128 v[56:59], v11 offset:128
    ds_read_b128 v[60:63], v11 offset:192
    ds_read_b128 v[64:67], v11 offset:256
    ds_read_b128 v[68:71], v11 offset:320
    ds_read_b128 v[72:75], v11 offset:384
    ds_read_b128 v[76:79], v11 offset:448
    ds_read_b128 v[80:83], v11 offset:512
    ds_read_b128 v[84:87], v11 offset:576
    ds_read_b128 v[88:91], v11 offset:640
    ds_read_b128 v[92:95], v11 offset:704
    ds_read_b128 v[96:99], v11 offset:768
    ds_read_b128 v[100:103], v11 offset:832
    s_mov_b32 s12, 0x40000
L_lw_9:
    ds_read_b32 v2, v1 offset:8
    s_waitcnt lgkmcnt(0)
    v_cmp_le_i32 vcc, 10, v2
    s_cbranch_vccnz L_lwd_10
    s_sub_u32 s12, s12, 1
    s_cbranch_scc0 L_lw_9
L_lwd_10:
    ds_read_b64_tr_b16 v[104:105], v12 offset:0
    ds_read_b64_tr_b16 v[106:107], v12 offset:2048
    ds_read_b64_tr_b16 v[108:109], v12 offset:4096
    ds_read_b64_tr_b16 v[110:111], v12 offset:6144
    ds_read_b64_tr_b16 v[112:113], v12 offset:8192
    ds_read_b64_tr_b16 v[114:115], v12 offset:10240
    ds_read_b64_tr_b16 v[116:117], v12 offset:12288
    ds_read_b64_tr_b16 v[118:119], v12 offset:14336
    ds_read_b64_tr_b16 v[120:121], v12 offset:16384
    ds_read_b64_tr_b16 v[122:123], v12 offset:18432
    ds_read_b64_tr_b16 v[124:125], v12 offset:20480
    ds_read_b64_tr_b16 v[126:127], v12 offset:22528
    ds_read_b64_tr_b16 v[128:129], v12 offset:24576
    ds_read_b64_tr_b16 v[130:131], v12 offset:26624
    s_waitcnt lgkmcnt(12)
    v_mfma_f32_16x16x32_bf16 v[132:135], v[48:51], v[104:107], 0
    s_waitcnt lgkmcnt(10)
    v_mfma_f32_16x16x32_bf16 v[132:135], v[52:55], v[108:111], v[132:135]
    s_waitcnt lgkmcnt(8)
    v_mfma_f32_16x16x32_bf16 v[132:135], v[56:59], v[112:115], v[132:135]
    s_waitcnt lgkmcnt(6)
    v_mfma_f32_16x16x32_bf16 v[132:135], v[60:63], v[116:119], v[132:135]
    s_waitcnt lgkmcnt(4)
    v_mfma_f32_16x16x32_bf16 v[132:135], v[64:67], v[120:123], v[132:135]
    s_waitcnt lgkmcnt(2)
    v_mfma_f32_16x16x32_bf16 v[132:135], v[68:71], v[124:127], v[132:135]
    s_waitcnt lgkmcnt(0)
    v_mfma_f32_16x16x32_bf16 v[132:135], v[72:75], v[128:131], v[132:135]
    s_mov_b32 s12, 0x40000
L_lw_11:
    ds_read_b32 v2, v1 offset:8
    s_waitcnt lgkmcnt(0)
    v_cmp_le_i32 vcc, 17, v2
    s_cbranch_vccnz L_lwd_12
    s_sub_u32 s12, s12, 1
    s_cbranch_scc0 L_lw_11
L_lwd_12:
    ds_read_b32 v3, v1 offset:28
    ds_read_b64_tr_b16 v[104:105], v12 offset:28672
    ds_read_b64_tr_b16 v[106:107], v12 offset:30720
    ds_read_b64_tr_b16 v[108:109], v12 offset:32768
    ds_read_b64_tr_b16 v[110:111], v12 offset:34816
    ds_read_b64_tr_b16 v[112:113], v12 offset:36864
    ds_read_b64_tr_b16 v[114:115], v12 offset:38912
    ds_read_b64_tr_b16 v[116:117], v12 offset:40960
    ds_read_b64_tr_b16 v[118:119], v12 offset:43008
    ds_read_b64_tr_b16 v[120:121], v12 offset:45056
    ds_read_b64_tr_b16 v[122:123], v12 offset:47104
    ds_read_b64_tr_b16 v[124:125], v12 offset:49152
    ds_read_b64_tr_b16 v[126:127], v12 offset:51200
    ds_read_b64_tr_b16 v[128:129], v12 offset:53248
    ds_read_b64_tr_b16 v[130:131], v12 offset:55296
    s_waitcnt lgkmcnt(12)
    v_mfma_f32_16x16x32_bf16 v[132:135], v[76:79], v[104:107], v[132:135]
    s_waitcnt lgkmcnt(10)
    v_mfma_f32_16x16x32_bf16 v[132:135], v[80:83], v[108:111], v[132:135]
    s_waitcnt lgkmcnt(8)
    v_mfma_f32_16x16x32_bf16 v[132:135], v[84:87], v[112:115], v[132:135]
    s_waitcnt lgkmcnt(6)
    v_mfma_f32_16x16x32_bf16 v[132:135], v[88:91], v[116:119], v[132:135]
    s_waitcnt lgkmcnt(4)
    v_mfma_f32_16x16x32_bf16 v[132:135], v[92:95], v[120:123], v[132:135]
    s_waitcnt lgkmcnt(2)
    v_mfma_f32_16x16x32_bf16 v[132:135], v[96:99], v[124:127], v[132:135]
    s_waitcnt lgkmcnt(0)
    v_mfma_f32_16x16x32_bf16 v[132:135], v[100:103], v[128:131], v[132:135]
    s_nop 7
    v_mov_b32_dpp v14, v132 quad_perm:[1,0,3,2] row_mask:0xf bank_mask:0xf
    v_cvt_pk_bf16_f32 v14, v132, v14
    s_mov_b32 exec_lo, 0x55555555
    s_mov_b32 exec_hi, 0x55555555
    buffer_store_dwordx2 v[14:15], v13, s[48:51], s46 offen
    v_cmp_ne_u32 vcc, 0, v3
    s_cbranch_vccnz L_nofar
    buffer_store_dwordx2 v[14:15], v13, s[48:51], s45 offen sc1
L_nofar:
    s_mov_b64 exec, 1
    v_mov_b32 v2, 1
    ds_add_u32 v1, v2 offset:16
    s_mov_b64 exec, -1
L_k:
    v_and_b32 v11, 6, v6
    v_xor_b32 v11, v11, v5
    v_lshlrev_b32 v11, 4, v11
    v_and_b32 v12, 7, v6
    v_lshl_add_u32 v11, v12, 7, v11
    v_lshrrev_b32 v12, 3, v6
    v_lshl_add_u32 v11, v12, 12, v11
    s_lshl_b32 s46, s3, 13
    v_add_u32 v11, s46, v11
    v_xor_b32 v12, 64, v11
    s_lshl_b32 s46, s3, 1
    s_add_u32 s46, s46, s64
    s_add_u32 s46, s46, 2
    s_mov_b32 s12, 0x40000
L_lw_13:
    ds_read_b32 v2, v1 offset:8
    s_waitcnt lgkmcnt(0)
    v_cmp_le_i32 vcc, s46, v2
    s_cbranch_vccnz L_lwd_14
    s_sleep 1
    s_sub_u32 s12, s12, 1
    s_cbranch_scc0 L_lw_13
L_lwd_14:
    ds_read_b128 v[16:19], v11 offset:0
    ds_read_b128 v[20:23], v12 offset:0
    ds_read_b128 v[24:27], v11 offset:1024
    ds_read_b128 v[28:31], v12 offset:1024
    ds_read_b128 v[32:35], v11 offset:2048
    ds_read_b128 v[36:39], v12 offset:2048
    ds_read_b128 v[40:43], v11 offset:3072
    ds_read_b128 v[44:47], v12 offset:3072
    v_and_b32 v11, 1, v0
    v_lshlrev_b32 v12, 8, v11
    v_lshl_add_u32 v12, v5, 3, v12
    s_lshl_b32 s46, s3, 5
    s_add_u32 s46, s46, 135808
    v_add_u32 v12, s46, v12
    v_mul_u32_u24 v11, 544, v11
    v_lshl_add_u32 v11, v5, 4, v11
    v_add_u32 v11, 134720, v11
    v_lshlrev_b32 v13, 3, v0
    v_add_u32 v13, 135808, v13
    v_lshrrev_b32 v14, 5, v0
    v_mul_u32_u24 v15, 288, v14
    v_bfe_u32 v3, v0, 3, 2
    v_lshl_add_u32 v15, v3, 6, v15
    v_lshl_add_u32 v15, v8, 4, v15
    v_and_b32 v3, 4, v0
    v_lshl_add_u32 v15, v3, 1, v15
    v_add_u32 v15, 136320, v15
    s_mov_b32 s57, 0x3db8aa3b
    s_waitcnt lgkmcnt(0)
    v_lshrrev_b32 v136, 3, v6
    v_mul_u32_u24 v136, 288, v136
    v_lshl_add_u32 v136, v5, 4, v136
    v_add_u32 v136, 136320, v136
    v_lshrrev_b32 v137, 3, v9
    v_lshlrev_b32 v137, 12, v137
    v_and_b32 v138, 7, v9
    v_lshl_add_u32 v137, v138, 7, v137
    v_lshl_add_u32 v137, v8, 3, v137
    s_lshr_b32 s46, s3, 1
    s_lshl_b32 s46, s46, 10
    s_add_u32 s46, s46, 65536
    v_add_u32 v137, s46, v137
    s_and_b32 s46, s3, 1
    s_lshl_b32 s46, s46, 1
    v_xor_b32 v138, s46, v10
    v_xor_b32 v139, 1, v138
    v_lshl_add_u32 v138, v138, 5, v137
    v_lshl_add_u32 v139, v139, 5, v137
    v_lshrrev_b32 v140, 3, v6
    v_lshlrev_b32 v140, 15, v140
    v_lshl_add_u32 v140, v5, 4, v140
    s_lshl_b32 s46, s40, 3
    s_lshr_b32 s47, s3, 1
    s_add_u32 s46, s46, s47
    s_lshl_b32 s46, s46, 13
    s_lshl_b32 s47, s41, 8
    s_add_u32 s46, s46, s47
    s_and_b32 s47, s3, 1
    s_lshl_b32 s47, s47, 7
    s_add_u32 s46, s46, s47
    s_add_u32 s58, s46, 1048576
    v_mov_b32 v145, s15
    v_lshrrev_b32 v142, 3, v0
    v_and_b32 v144, 7, v0
    v_lshlrev_b32 v141, 8, v142
    v_lshl_add_u32 v141, v144, 4, v141
    v_lshlrev_b32 v142, 4, v142
    s_lshl_b32 s45, s61, 13
    s_lshr_b32 s46, s3, 1
    s_lshl_b32 s47, s46, 11
    s_add_u32 s45, s45, s47
    s_and_b32 s47, s3, 1
    s_lshl_b32 s47, s47, 7
    s_add_u32 s45, s45, s47
    s_add_u32 s66, s45, 1048576
    s_lshr_b32 s45, s61, 2
    s_lshl_b32 s45, s45, 9
    s_lshl_b32 s47, s46, 7
    s_add_u32 s45, s45, s47
    s_add_u32 s67, s45, 131072
    s_mul_i32 s46, s46, 144
    s_and_b32 s47, s3, 1
    s_lshl_b32 s47, s47, 6
    s_add_u32 s46, s46, s47
    s_add_u32 s46, s46, 136896
    v_lshlrev_b32 v143, 4, v8
    v_and_b32 v144, 4, v0
    v_lshl_add_u32 v143, v144, 1, v143
    v_and_b32 v144, 1, v5
    v_lshl_add_u32 v143, v144, 2, v143
    v_lshrrev_b32 v144, 1, v5
    v_lshl_add_u32 v143, v144, 1, v143
    v_add_u32 v143, s46, v143
    s_add_u32 s56, s64, 20
    s_mov_b32 s12, 0x40000
L_lw_15:
    ds_read_b32 v2, v1 offset:4
    s_waitcnt lgkmcnt(0)
    v_cmp_le_i32 vcc, 1, v2
    s_cbranch_vccnz L_lwd_16
    s_sleep 1
    s_sub_u32 s12, s12, 1
    s_cbranch_scc0 L_lw_15
L_lwd_16:
    ds_read_b128 v[48:51], v11 offset:0
    ds_read_b128 v[52:55], v11 offset:64
    ds_read_b128 v[56:59], v11 offset:128
    ds_read_b128 v[60:63], v11 offset:192
    ds_read_b128 v[64:67], v11 offset:256
    ds_read_b128 v[68:71], v11 offset:320
    ds_read_b128 v[72:75], v11 offset:384
    ds_read_b128 v[76:79], v11 offset:448
    ds_read_b32 v3, v1 offset:28
    s_waitcnt lgkmcnt(8)
    v_mfma_f32_16x16x32_bf16 v[80:83], v[16:19], v[48:51], 0
    s_waitcnt lgkmcnt(7)
    v_mfma_f32_16x16x32_bf16 v[80:83], v[20:23], v[52:55], v[80:83]
    s_waitcnt lgkmcnt(6)
    v_mfma_f32_16x16x32_bf16 v[80:83], v[24:27], v[56:59], v[80:83]
    s_waitcnt lgkmcnt(5)
    v_mfma_f32_16x16x32_bf16 v[80:83], v[28:31], v[60:63], v[80:83]
    s_waitcnt lgkmcnt(4)
    v_mfma_f32_16x16x32_bf16 v[80:83], v[32:35], v[64:67], v[80:83]
    s_waitcnt lgkmcnt(3)
    v_mfma_f32_16x16x32_bf16 v[80:83], v[36:39], v[68:71], v[80:83]
    s_waitcnt lgkmcnt(2)
    v_mfma_f32_16x16x32_bf16 v[80:83], v[40:43], v[72:75], v[80:83]
    s_waitcnt lgkmcnt(1)
    v_mfma_f32_16x16x32_bf16 v[80:83], v[44:47], v[76:79], v[80:83]
    s_nop 7
    v_cvt_pk_bf16_f32 v84, v80, v81
    v_cvt_pk_bf16_f32 v85, v82, v83
    s_mov_b32 exec_lo, 0x00030003
    s_mov_b32 exec_hi, 0x00030003
    ds_write_b64 v12, v[84:85]
    s_waitcnt lgkmcnt(0)
    v_readfirstlane_b32 s65, v3
    s_mov_b64 exec, 1
    v_mov_b32 v2, 1
    ds_add_u32 v1, v2 offset:20
    s_mov_b64 exec, -1
    s_mov_b32 s12, 0x40000
L_lw_17:
    ds_read_b32 v2, v1 offset:20
    s_waitcnt lgkmcnt(0)
    v_cmp_le_i32 vcc, 8, v2
    s_cbranch_vccnz L_lwd_18
    s_sub_u32 s12, s12, 1
    s_cbranch_scc0 L_lw_17
L_lwd_18:
    ds_read_b64 v[86:87], v13
    s_waitcnt lgkmcnt(0)
    v_lshlrev_b32 v92, 16, v86
    v_and_b32 v93, 0xffff0000, v86
    v_lshlrev_b32 v94, 16, v87
    v_and_b32 v95, 0xffff0000, v87
    v_max_f32 v96, v92, v93
    v_max3_f32 v96, v96, v94, v95
    s_nop 1
    v_max_f32_dpp v96, v96, v96 row_ror:8 row_mask:0xf bank_mask:0xf
    s_nop 1
    v_max_f32_dpp v96, v96, v96 row_ror:4 row_mask:0xf bank_mask:0xf
    s_nop 1
    v_max_f32_dpp v96, v96, v96 row_ror:2 row_mask:0xf bank_mask:0xf
    s_nop 1
    v_max_f32_dpp v96, v96, v96 row_ror:1 row_mask:0xf bank_mask:0xf
    v_mov_b32 v97, v96
    s_nop 1
    v_permlane16_swap_b32 v96, v97
    v_max_f32 v96, v96, v97
    v_sub_f32 v92, v92, v96
    v_sub_f32 v93, v93, v96
    v_sub_f32 v94, v94, v96
    v_sub_f32 v95, v95, v96
    v_mul_f32 v92, s57, v92
    v_mul_f32 v93, s57, v93
    v_mul_f32 v94, s57, v94
    v_mul_f32 v95, s57, v95
    v_exp_f32 v92, v92
    v_exp_f32 v93, v93
    v_exp_f32 v94, v94
    v_exp_f32 v95, v95
    v_add_f32 v98, v92, v93
    v_add_f32 v99, v94, v95
    v_cvt_pk_bf16_f32 v92, v92, v93
    v_cvt_pk_bf16_f32 v93, v94, v95
    v_add_f32 v98, v98, v99
    ds_write_b64 v15, v[92:93]
    s_cmp_lg_u32 s3, 0
    s_cbranch_scc1 L_nostat
    v_add_f32_dpp v98, v98, v98 row_ror:8 row_mask:0xf bank_mask:0xf
    s_nop 1
    v_add_f32_dpp v98, v98, v98 row_ror:4 row_mask:0xf bank_mask:0xf
    s_nop 1
    v_add_f32_dpp v98, v98, v98 row_ror:2 row_mask:0xf bank_mask:0xf
    s_nop 1
    v_add_f32_dpp v98, v98, v98 row_ror:1 row_mask:0xf bank_mask:0xf
    v_mov_b32 v97, v98
    s_nop 1
    v_permlane16_swap_b32 v98, v97
    v_add_f32 v98, v98, v97
    v_mov_b32 v97, s15
    v_mov_b32 v99, s15
    v_lshlrev_b32 v14, 9, v14
    s_lshl_b32 s46, s40, 10
    s_lshl_b32 s47, s41, 4
    s_add_u32 s46, s46, s47
    s_add_u32 s46, s46, 131072
    s_mov_b32 exec_lo, 1
    s_mov_b32 exec_hi, 1
    s_cmp_eq_u32 s65, 0
    s_cbranch_scc1 L_far_19
    buffer_store_dwordx4 v[96:99], v14, s[48:51], s46 offen
    s_branch L_st_20
L_far_19:
    buffer_store_dwordx4 v[96:99], v14, s[48:51], s46 offen sc1
L_st_20:
    s_mov_b64 exec, -1
L_nostat:
    s_waitcnt lgkmcnt(0)
    ds_read_b128 v[16:19], v136 offset:0
    ds_read_b128 v[20:23], v136 offset:64
    ds_read_b128 v[24:27], v136 offset:128
    ds_read_b128 v[28:31], v136 offset:192
    s_mov_b32 s12, 0x40000
L_lw_21:
    ds_read_b32 v2, v1 offset:8
    s_waitcnt lgkmcnt(0)
    v_cmp_le_i32 vcc, s56, v2
    s_cbranch_vccnz L_lwd_22
    s_sleep 1
    s_sub_u32 s12, s12, 1
    s_cbranch_scc0 L_lw_21
L_lwd_22:
    ds_read_b64_tr_b16 v[92:93], v138 offset:0
    ds_read_b64_tr_b16 v[94:95], v138 offset:8192
    ds_read_b64_tr_b16 v[96:97], v139 offset:0
    ds_read_b64_tr_b16 v[98:99], v139 offset:8192
    s_add_u32 s56, s56, 4
    s_waitcnt lgkmcnt(2)
    v_mfma_f32_16x16x32_bf16 v[80:83], v[92:95], v[16:19], 0
    s_waitcnt lgkmcnt(0)
    v_mfma_f32_16x16x32_bf16 v[84:87], v[96:99], v[16:19], 0
    s_mov_b32 s12, 0x40000
L_lw_23:
    ds_read_b32 v2, v1 offset:8
    s_waitcnt lgkmcnt(0)
    v_cmp_le_i32 vcc, s56, v2
    s_cbranch_vccnz L_lwd_24
    s_sleep 1
    s_sub_u32 s12, s12, 1
    s_cbranch_scc0 L_lw_23
L_lwd_24:
    ds_read_b64_tr_b16 v[92:93], v138 offset:16384
    ds_read_b64_tr_b16 v[94:95], v138 offset:24576
    ds_read_b64_tr_b16 v[96:97], v139 offset:16384
    ds_read_b64_tr_b16 v[98:99], v139 offset:24576
    s_add_u32 s56, s56, 4
    s_waitcnt lgkmcnt(2)
    v_mfma_f32_16x16x32_bf16 v[80:83], v[92:95], v[20:23], v[80:83]
    s_waitcnt lgkmcnt(0)
    v_mfma_f32_16x16x32_bf16 v[84:87], v[96:99], v[20:23], v[84:87]
    s_mov_b32 s12, 0x40000
L_lw_25:
    ds_read_b32 v2, v1 offset:8
    s_waitcnt lgkmcnt(0)
    v_cmp_le_i32 vcc, s56, v2
    s_cbranch_vccnz L_lwd_26
    s_sleep 1
    s_sub_u32 s12, s12, 1
    s_cbranch_scc0 L_lw_25
L_lwd_26:
    ds_read_b64_tr_b16 v[92:93], v138 offset:32768
    ds_read_b64_tr_b16 v[94:95], v138 offset:40960
    ds_read_b64_tr_b16 v[96:97], v139 offset:32768
    ds_read_b64_tr_b16 v[98:99], v139 offset:40960
    s_add_u32 s56, s56, 4
    s_waitcnt lgkmcnt(2)
    v_mfma_f32_16x16x32_bf16 v[80:83], v[92:95], v[24:27], v[80:83]
    s_waitcnt lgkmcnt(0)
    v_mfma_f32_16x16x32_bf16 v[84:87], v[96:99], v[24:27], v[84:87]
    s_cmp_eq_u32 s60, 2
    s_cbranch_scc0 L_nostl
    buffer_load_dwordx4 v[48:51], v142, s[48:51], s67 offen sc1
L_nostl:
    s_lshl_b32 s47, s40, 7
    s_add_u32 s47, s47, 159744
    s_lshl_b32 s45, s41, 2
    v_mov_b32 v60, s45
    s_sub_u32 s46, s56, 1
    s_mov_b32 s12, 0x40000
L_lw_27:
    ds_read_b32 v2, v1 offset:8
    s_waitcnt lgkmcnt(0)
    v_cmp_le_i32 vcc, s46, v2
    s_cbranch_vccnz L_lwd_28
    s_sub_u32 s12, s12, 1
    s_cbranch_scc0 L_lw_27
L_lwd_28:
    s_mov_b32 s12, 0x40000
L_vlast:
    ds_read_b32 v2, v1 offset:8
    ds_read_b64_tr_b16 v[92:93], v138 offset:49152
    ds_read_b64_tr_b16 v[94:95], v138 offset:57344
    ds_read_b64_tr_b16 v[96:97], v139 offset:49152
    ds_read_b64_tr_b16 v[98:99], v139 offset:57344
    s_waitcnt lgkmcnt(4)
    v_cmp_le_i32 vcc, s56, v2
    s_cbranch_vccnz L_vok
    s_waitcnt lgkmcnt(0)
    s_sub_u32 s12, s12, 1
    s_cbranch_scc0 L_vlast
L_vok:
    s_waitcnt lgkmcnt(2)
    v_mfma_f32_16x16x32_bf16 v[80:83], v[92:95], v[28:31], v[80:83]
    s_waitcnt lgkmcnt(0)
    v_mfma_f32_16x16x32_bf16 v[84:87], v[96:99], v[28:31], v[84:87]
    s_mov_b32 exec_lo, 0x01010101
    s_mov_b32 exec_hi, 0x01010101
    s_cmp_eq_u32 s65, 0
    s_nop 2
    v_perm_b32 v88, v80, v145, s4
    v_perm_b32 v89, v81, v145, s5
    v_perm_b32 v90, v82, v145, s6
    v_perm_b32 v91, v83, v145, s7
    s_cbranch_scc1 L_ofar
    buffer_store_dwordx4 v[88:91], v140, s[48:51], s58 offen
    v_perm_b32 v92, v84, v145, s4
    v_perm_b32 v93, v85, v145, s5
    v_perm_b32 v94, v86, v145, s6
    v_perm_b32 v95, v87, v145, s7
    buffer_store_dwordx4 v[92:95], v140, s[48:51], s58 offen offset:64
L_ostored:
    s_cmp_eq_u32 s3, 7
    s_cbranch_scc0 L_nomark2
    s_mov_b64 exec, 1
    s_cmp_eq_u32 s65, 0
    s_cbranch_scc1 L_far_29
    buffer_store_dword v145, v60, s[48:51], s47 offen
    s_branch L_st_30
L_far_29:
    buffer_store_dword v145, v60, s[48:51], s47 offen sc1
L_st_30:
L_nomark2:
    s_mov_b64 exec, -1
    s_cmp_eq_u32 s60, 2
    s_cbranch_scc0 L_notwo
    buffer_load_dwordx4 v[64:67], v141, s[48:51], s66 offen sc1
    s_waitcnt vmcnt(3)
    v_cmp_ne_u32 vcc, s15, v49
    v_cmp_ne_u32 s[10:11], s15, v51
    s_or_b64 vcc, vcc, s[10:11]
    s_cbranch_scc1 L_stretry
L_stok:
    v_mov_b32 v56, v48
    s_nop 1
    v_max_f32_dpp v56, v56, v56 row_ror:8 row_mask:0xf bank_mask:0xf
    v_mov_b32 v57, v56
    s_nop 1
    v_permlane16_swap_b32 v56, v57
    v_max_f32 v56, v56, v57
    v_mov_b32 v57, v56
    s_nop 1
    v_permlane32_swap_b32 v56, v57
    v_max_f32 v56, v56, v57
    v_sub_f32 v14, v48, v56
    v_mul_f32 v14, s57, v14
    v_exp_f32 v14, v14
    s_mov_b32 s13, 0x4000
    v_mul_f32 v56, v14, v50
    s_nop 1
    v_add_f32_dpp v56, v56, v56 row_ror:8 row_mask:0xf bank_mask:0xf
    v_mov_b32 v57, v56
    s_nop 1
    v_permlane16_swap_b32 v56, v57
    v_add_f32 v56, v56, v57
    v_mov_b32 v57, v56
    s_nop 1
    v_permlane32_swap_b32 v56, v57
    v_add_f32 v56, v56, v57
    v_rcp_f32 v56, v56
    s_nop 0
    v_mul_f32 v14, v14, v56
    buffer_load_dwordx4 v[68:71], v141, s[48:51], s66 offen sc1
L_bchk:
    s_waitcnt vmcnt(1)
    v_xor_b32 v64, s16, v64
    v_xor_b32 v65, s17, v65
    v_xor_b32 v66, s18, v66
    v_xor_b32 v67, s19, v67
    v_or3_b32 v57, v64, v65, v66
    v_bitop3_b32 v57, v57, v67, s20 bitop3:0xa8
    v_cmp_ne_u32 vcc, 0, v57
    s_cbranch_vccz L_bok
    buffer_load_dwordx4 v[64:67], v141, s[48:51], s66 offen sc1
    s_waitcnt vmcnt(1)
    v_xor_b32 v68, s16, v68
    v_xor_b32 v69, s17, v69
    v_xor_b32 v70, s18, v70
    v_xor_b32 v71, s19, v71
    v_or3_b32 v57, v68, v69, v70
    v_bitop3_b32 v57, v57, v71, s20 bitop3:0xa8
    v_cmp_ne_u32 vcc, 0, v57
    s_cbranch_vccz L_bok2
    buffer_load_dwordx4 v[68:71], v141, s[48:51], s66 offen sc1
    s_sub_u32 s13, s13, 1
    s_cbranch_scc0 L_bchk
L_bok2:
    v_mul_f32 v72, v68, v14
    v_mul_f32 v73, v69, v14
    v_mul_f32 v74, v70, v14
    v_mul_f32 v75, v71, v14
    s_branch L_bsum
L_bok:
    v_mul_f32 v72, v64, v14
    v_mul_f32 v73, v65, v14
    v_mul_f32 v74, v66, v14
    v_mul_f32 v75, v67, v14
L_bsum:
    v_permlane32_swap_b32 v72, v73
    s_nop 0
    v_permlane32_swap_b32 v74, v75
    v_add_f32 v72, v72, v73
    v_add_f32 v74, v74, v75
    s_nop 1
    v_permlane16_swap_b32 v72, v74
    v_add_f32 v72, v72, v74
    s_nop 1
    v_add_f32_dpp v72, v72, v72 row_ror:8 row_mask:0xf bank_mask:0xf
    v_cvt_pk_bf16_f32 v72, v72, v72
    ds_write_b16 v143, v72
    s_waitcnt lgkmcnt(0)
    s_barrier
    s_cmp_eq_u32 s3, 7
    s_cbranch_scc1 L_adone
L_ojob2:
    ds_read_b128 v[76:79], v101
    ds_read_b128 v[80:83], v101 offset:64
    s_waitcnt lgkmcnt(1)
    v_mfma_f32_16x16x32_bf16 v[48:51], v[76:79], v[104:107], 0
    v_mfma_f32_16x16x32_bf16 v[52:55], v[76:79], v[108:111], 0
    v_mfma_f32_16x16x32_bf16 v[56:59], v[76:79], v[112:115], 0
    v_mfma_f32_16x16x32_bf16 v[60:63], v[76:79], v[116:119], 0
    s_waitcnt lgkmcnt(0)
    v_mfma_f32_16x16x32_bf16 v[48:51], v[80:83], v[120:123], v[48:51]
    v_mfma_f32_16x16x32_bf16 v[52:55], v[80:83], v[124:127], v[52:55]
    v_mfma_f32_16x16x32_bf16 v[56:59], v[80:83], v[128:131], v[56:59]
    v_mfma_f32_16x16x32_bf16 v[60:63], v[80:83], v[132:135], v[60:63]
    s_nop 4
    v_perm_b32 v84, v48, v103, s4
    v_perm_b32 v85, v52, v103, s5
    v_perm_b32 v86, v56, v103, s6
    v_perm_b32 v87, v60, v103, s7
    buffer_store_dwordx4 v[84:87], v102, s[48:51], s59 offen sc1
L_adone:
    s_endpgm
L_ofar:
    buffer_store_dwordx4 v[88:91], v140, s[48:51], s58 offen sc1
    v_perm_b32 v92, v84, v145, s4
    v_perm_b32 v93, v85, v145, s5
    v_perm_b32 v94, v86, v145, s6
    v_perm_b32 v95, v87, v145, s7
    buffer_store_dwordx4 v[92:95], v140, s[48:51], s58 offen offset:64 sc1
    s_branch L_ostored
L_notwo:
    s_cmp_eq_u32 s60, 3
    s_cbranch_scc0 L_adone
    s_cmp_eq_u32 s3, 7
    s_cbranch_scc1 L_adone
    s_mov_b32 s12, 0x40000
L_lw_31:
    ds_read_b32 v2, v1 offset:24
    s_waitcnt lgkmcnt(0)
    v_cmp_le_i32 vcc, 8, v2
    s_cbranch_vccnz L_lwd_32
    s_sub_u32 s12, s12, 1
    s_cbranch_scc0 L_lw_31
L_lwd_32:
    s_branch L_ojob2
L_stretry:
    s_mov_b32 s12, 0x4000
L_pl_33:
    buffer_load_dwordx4 v[48:51], v142, s[48:51], s67 offen sc1
    s_waitcnt vmcnt(0)
    v_cmp_ne_u32 vcc, s15, v49
    v_cmp_ne_u32 s[10:11], s15, v51
    s_or_b64 vcc, vcc, s[10:11]
    s_cbranch_scc0 L_pld_34
    s_sub_u32 s12, s12, 1
    s_cbranch_scc0 L_pl_33
L_pld_34:
    s_branch L_stok
L_helper:
    s_setprio 3
    s_mov_b32 s52, s16
    s_mov_b32 s53, s17
    s_mov_b32 s54, 3584
    s_mov_b32 s55, 0x20000
    s_getreg_b32 s65, hwreg(HW_REG_XCC_ID, 0, 4)
    s_cmp_eq_u32 s60, 1
    s_cbranch_scc0 L_noln0
    v_mul_u32_u24 v9, 896, v5
    v_lshl_add_u32 v9, v6, 3, v9
    buffer_load_dwordx2 v[16:17], v9, s[52:55], 0 offen offset:0
    buffer_load_dwordx2 v[18:19], v9, s[52:55], 0 offen offset:128
    buffer_load_dwordx2 v[20:21], v9, s[52:55], 0 offen offset:256
    buffer_load_dwordx2 v[22:23], v9, s[52:55], 0 offen offset:384
    buffer_load_dwordx2 v[24:25], v9, s[52:55], 0 offen offset:512
    buffer_load_dwordx2 v[26:27], v9, s[52:55], 0 offen offset:640
    buffer_load_dwordx2 v[28:29], v9, s[52:55], 0 offen offset:768
    v_mul_u32_u24 v9, 912, v5
    v_lshrrev_b32 v10, 3, v6
    v_lshl_add_u32 v9, v10, 6, v9
    v_lshl_add_u32 v9, v8, 4, v9
    v_and_b32 v10, 4, v6
    v_lshl_add_u32 v9, v10, 1, v9
    v_add_u32 v9, 131072, v9
L_noln0:
    s_barrier
    s_waitcnt lgkmcnt(0)
    s_mul_i32 s15, s14, 0x9E3779B1
    s_add_u32 s15, s15, 0x632BE5AB
    s_lshl_b32 s58, s40, 7
    s_add_u32 s58, s58, 147456
    s_add_u32 s8, s65, s15
    s_mov_b32 s9, s8
    v_mov_b32 v66, s8
    s_lshl_b32 s45, s41, 2
    v_mov_b32 v68, s45
    s_mov_b64 exec, 1
    buffer_store_dword v66, v68, s[48:51], s58 offen
    s_mov_b64 exec, -1
    s_cmp_eq_u32 s41, 8
    s_cbranch_scc0 L_notb
    v_mov_b32 v70, s70
    v_mov_b32 v71, s15
    v_lshlrev_b32 v72, 10, v0
    s_lshl_b32 s45, s40, 7
    s_add_u32 s45, s45, 155648
    s_mov_b64 exec, 3
    buffer_store_dwordx2 v[70:71], v72, s[48:51], s45 offen sc1
    s_mov_b64 exec, -1
L_notb:
    s_add_u32 s4, s38, 155648
    s_addc_u32 s5, s39, 0
    s_load_dwordx2 s[16:17], s[4:5], 0
    s_load_dwordx2 s[18:19], s[4:5], 128
    s_load_dwordx2 s[20:21], s[4:5], 256
    s_load_dwordx2 s[22:23], s[4:5], 384
    s_load_dwordx2 s[24:25], s[4:5], 512
    s_load_dwordx2 s[26:27], s[4:5], 640
    s_load_dwordx2 s[28:29], s[4:5], 768
    s_load_dwordx2 s[30:31], s[4:5], 896
    s_mov_b32 s6, 0
    s_waitcnt lgkmcnt(0)
    s_sub_u32 s7, s16, s70
    s_cmp_eq_u32 s17, s15
    s_cselect_b32 s7, s7, 0
    s_add_u32 s6, s6, s7
    s_sub_u32 s7, s18, s70
    s_cmp_eq_u32 s19, s15
    s_cselect_b32 s7, s7, 0
    s_add_u32 s6, s6, s7
    s_sub_u32 s7, s20, s70
    s_cmp_eq_u32 s21, s15
    s_cselect_b32 s7, s7, 0
    s_add_u32 s6, s6, s7
    s_sub_u32 s7, s22, s70
    s_cmp_eq_u32 s23, s15
    s_cselect_b32 s7, s7, 0
    s_add_u32 s6, s6, s7
    s_sub_u32 s7, s24, s70
    s_cmp_eq_u32 s25, s15
    s_cselect_b32 s7, s7, 0
    s_add_u32 s6, s6, s7
    s_sub_u32 s7, s26, s70
    s_cmp_eq_u32 s27, s15
    s_cselect_b32 s7, s7, 0
    s_add_u32 s6, s6, s7
    s_sub_u32 s7, s28, s70
    s_cmp_eq_u32 s29, s15
    s_cselect_b32 s7, s7, 0
    s_add_u32 s6, s6, s7
    s_sub_u32 s7, s30, s70
    s_cmp_eq_u32 s31, s15
    s_cselect_b32 s7, s7, 0
    s_add_u32 s6, s6, s7
    s_ashr_i32 s6, s6, 3
    s_min_i32 s6, s6, 300
    s_max_i32 s6, s6, -300
    v_mov_b32 v2, s6
    ds_write_b32 v1, v2 offset:32
    s_cmp_eq_u32 s60, 1
    s_cbranch_scc0 L_noln
    s_waitcnt vmcnt(1)
    v_lshlrev_b32 v32, 16, v16
    v_and_b32 v33, 0xffff0000, v16
    v_lshlrev_b32 v34, 16, v17
    v_and_b32 v35, 0xffff0000, v17
    v_lshlrev_b32 v36, 16, v18
    v_and_b32 v37, 0xffff0000, v18
    v_lshlrev_b32 v38, 16, v19
    v_and_b32 v39, 0xffff0000, v19
    v_lshlrev_b32 v40, 16, v20
    v_and_b32 v41, 0xffff0000, v20
    v_lshlrev_b32 v42, 16, v21
    v_and_b32 v43, 0xffff0000, v21
    v_lshlrev_b32 v44, 16, v22
    v_and_b32 v45, 0xffff0000, v22
    v_lshlrev_b32 v46, 16, v23
    v_and_b32 v47, 0xffff0000, v23
    v_lshlrev_b32 v48, 16, v24
    v_and_b32 v49, 0xffff0000, v24
    v_lshlrev_b32 v50, 16, v25
    v_and_b32 v51, 0xffff0000, v25
    v_lshlrev_b32 v52, 16, v26
    v_and_b32 v53, 0xffff0000, v26
    v_lshlrev_b32 v54, 16, v27
    v_and_b32 v55, 0xffff0000, v27
    v_lshlrev_b32 v56, 16, v28
    v_and_b32 v57, 0xffff0000, v28
    v_lshlrev_b32 v58, 16, v29
    v_and_b32 v59, 0xffff0000, v29
    v_pk_add_f32 v[60:61], v[32:33], v[34:35]
    v_pk_add_f32 v[60:61], v[60:61], v[36:37]
    v_pk_add_f32 v[60:61], v[60:61], v[38:39]
    v_pk_add_f32 v[60:61], v[60:61], v[40:41]
    v_pk_add_f32 v[60:61], v[60:61], v[42:43]
    v_pk_add_f32 v[60:61], v[60:61], v[44:45]
    v_pk_add_f32 v[60:61], v[60:61], v[46:47]
    v_pk_add_f32 v[60:61], v[60:61], v[48:49]
    v_pk_add_f32 v[60:61], v[60:61], v[50:51]
    v_pk_add_f32 v[60:61], v[60:61], v[52:53]
    v_pk_add_f32 v[60:61], v[60:61], v[54:55]
    v_pk_add_f32 v[60:61], v[60:61], v[56:57]
    v_pk_add_f32 v[60:61], v[60:61], v[58:59]
    v_add_f32 v60, v60, v61
    s_nop 1
    v_add_f32_dpp v60, v60, v60 row_ror:8 row_mask:0xf bank_mask:0xf
    s_nop 1
    v_add_f32_dpp v60, v60, v60 row_ror:4 row_mask:0xf bank_mask:0xf
    s_nop 1
    v_add_f32_dpp v60, v60, v60 row_ror:2 row_mask:0xf bank_mask:0xf
    s_nop 1
    v_add_f32_dpp v60, v60, v60 row_ror:1 row_mask:0xf bank_mask:0xf
    v_mul_f32 v60, 0x3b124925, v60
    v_mov_b32 v61, v60
    v_pk_add_f32 v[64:65], v[32:33], v[60:61] neg_lo:[0,1] neg_hi:[0,1]
    v_pk_mul_f32 v[62:63], v[64:65], v[64:65]
    v_pk_add_f32 v[64:65], v[34:35], v[60:61] neg_lo:[0,1] neg_hi:[0,1]
    v_pk_fma_f32 v[62:63], v[64:65], v[64:65], v[62:63]
    v_pk_add_f32 v[64:65], v[36:37], v[60:61] neg_lo:[0,1] neg_hi:[0,1]
    v_pk_fma_f32 v[62:63], v[64:65], v[64:65], v[62:63]
    v_pk_add_f32 v[64:65], v[38:39], v[60:61] neg_lo:[0,1] neg_hi:[0,1]
    v_pk_fma_f32 v[62:63], v[64:65], v[64:65], v[62:63]
    v_pk_add_f32 v[64:65], v[40:41], v[60:61] neg_lo:[0,1] neg_hi:[0,1]
    v_pk_fma_f32 v[62:63], v[64:65], v[64:65], v[62:63]
    v_pk_add_f32 v[64:65], v[42:43], v[60:61] neg_lo:[0,1] neg_hi:[0,1]
    v_pk_fma_f32 v[62:63], v[64:65], v[64:65], v[62:63]
    v_pk_add_f32 v[64:65], v[44:45], v[60:61] neg_lo:[0,1] neg_hi:[0,1]
    v_pk_fma_f32 v[62:63], v[64:65], v[64:65], v[62:63]
    v_pk_add_f32 v[64:65], v[46:47], v[60:61] neg_lo:[0,1] neg_hi:[0,1]
    v_pk_fma_f32 v[62:63], v[64:65], v[64:65], v[62:63]
    v_pk_add_f32 v[64:65], v[48:49], v[60:61] neg_lo:[0,1] neg_hi:[0,1]
    v_pk_fma_f32 v[62:63], v[64:65], v[64:65], v[62:63]
    v_pk_add_f32 v[64:65], v[50:51], v[60:61] neg_lo:[0,1] neg_hi:[0,1]
    v_pk_fma_f32 v[62:63], v[64:65], v[64:65], v[62:63]
    v_pk_add_f32 v[64:65], v[52:53], v[60:61] neg_lo:[0,1] neg_hi:[0,1]
    v_pk_fma_f32 v[62:63], v[64:65], v[64:65], v[62:63]
    v_pk_add_f32 v[64:65], v[54:55], v[60:61] neg_lo:[0,1] neg_hi:[0,1]
    v_pk_fma_f32 v[62:63], v[64:65], v[64:65], v[62:63]
    v_pk_add_f32 v[64:65], v[56:57], v[60:61] neg_lo:[0,1] neg_hi:[0,1]
    v_pk_fma_f32 v[62:63], v[64:65], v[64:65], v[62:63]
    v_pk_add_f32 v[64:65], v[58:59], v[60:61] neg_lo:[0,1] neg_hi:[0,1]
    v_pk_fma_f32 v[62:63], v[64:65], v[64:65], v[62:63]
    v_add_f32 v62, v62, v63
    s_nop 1
    v_add_f32_dpp v62, v62, v62 row_ror:8 row_mask:0xf bank_mask:0xf
    s_nop 1
    v_add_f32_dpp v62, v62, v62 row_ror:4 row_mask:0xf bank_mask:0xf
    s_nop 1
    v_add_f32_dpp v62, v62, v62 row_ror:2 row_mask:0xf bank_mask:0xf
    s_nop 1
    v_add_f32_dpp v62, v62, v62 row_ror:1 row_mask:0xf bank_mask:0xf
    v_mul_f32 v62, 0x3b124925, v62
    v_cvt_pk_bf16_f32 v62, v62, v62
    v_and_b32 v62, 0xffff0000, v62
    v_add_f32 v62, 0x3727c5ac, v62
    v_cvt_pk_bf16_f32 v62, v62, v62
    v_and_b32 v62, 0xffff0000, v62
    v_sqrt_f32 v62, v62
    s_nop 0
    v_cvt_pk_bf16_f32 v62, v62, v62
    v_and_b32 v62, 0xffff0000, v62
    v_rcp_f32 v62, v62
    v_cvt_pk_bf16_f32 v60, v60, v60
    v_and_b32 v60, 0xffff0000, v60
    v_mov_b32 v61, v60
    v_mov_b32 v63, v62
    v_pk_add_f32 v[64:65], v[32:33], v[60:61] neg_lo:[0,1] neg_hi:[0,1]
    v_cvt_pk_bf16_f32 v64, v64, v65
    v_and_b32 v65, 0xffff0000, v64
    v_lshlrev_b32 v64, 16, v64
    v_pk_mul_f32 v[64:65], v[64:65], v[62:63]
    v_cvt_pk_bf16_f32 v16, v64, v65
    v_pk_add_f32 v[64:65], v[34:35], v[60:61] neg_lo:[0,1] neg_hi:[0,1]
    v_cvt_pk_bf16_f32 v64, v64, v65
    v_and_b32 v65, 0xffff0000, v64
    v_lshlrev_b32 v64, 16, v64
    v_pk_mul_f32 v[64:65], v[64:65], v[62:63]
    v_cvt_pk_bf16_f32 v17, v64, v65
    v_pk_add_f32 v[64:65], v[36:37], v[60:61] neg_lo:[0,1] neg_hi:[0,1]
    v_cvt_pk_bf16_f32 v64, v64, v65
    v_and_b32 v65, 0xffff0000, v64
    v_lshlrev_b32 v64, 16, v64
    v_pk_mul_f32 v[64:65], v[64:65], v[62:63]
    v_cvt_pk_bf16_f32 v18, v64, v65
    v_pk_add_f32 v[64:65], v[38:39], v[60:61] neg_lo:[0,1] neg_hi:[0,1]
    v_cvt_pk_bf16_f32 v64, v64, v65
    v_and_b32 v65, 0xffff0000, v64
    v_lshlrev_b32 v64, 16, v64
    v_pk_mul_f32 v[64:65], v[64:65], v[62:63]
    v_cvt_pk_bf16_f32 v19, v64, v65
    v_pk_add_f32 v[64:65], v[40:41], v[60:61] neg_lo:[0,1] neg_hi:[0,1]
    v_cvt_pk_bf16_f32 v64, v64, v65
    v_and_b32 v65, 0xffff0000, v64
    v_lshlrev_b32 v64, 16, v64
    v_pk_mul_f32 v[64:65], v[64:65], v[62:63]
    v_cvt_pk_bf16_f32 v20, v64, v65
    v_pk_add_f32 v[64:65], v[42:43], v[60:61] neg_lo:[0,1] neg_hi:[0,1]
    v_cvt_pk_bf16_f32 v64, v64, v65
    v_and_b32 v65, 0xffff0000, v64
    v_lshlrev_b32 v64, 16, v64
    v_pk_mul_f32 v[64:65], v[64:65], v[62:63]
    v_cvt_pk_bf16_f32 v21, v64, v65
    v_pk_add_f32 v[64:65], v[44:45], v[60:61] neg_lo:[0,1] neg_hi:[0,1]
    v_cvt_pk_bf16_f32 v64, v64, v65
    v_and_b32 v65, 0xffff0000, v64
    v_lshlrev_b32 v64, 16, v64
    v_pk_mul_f32 v[64:65], v[64:65], v[62:63]
    v_cvt_pk_bf16_f32 v22, v64, v65
    v_pk_add_f32 v[64:65], v[46:47], v[60:61] neg_lo:[0,1] neg_hi:[0,1]
    v_cvt_pk_bf16_f32 v64, v64, v65
    v_and_b32 v65, 0xffff0000, v64
    v_lshlrev_b32 v64, 16, v64
    v_pk_mul_f32 v[64:65], v[64:65], v[62:63]
    v_cvt_pk_bf16_f32 v23, v64, v65
    v_pk_add_f32 v[64:65], v[48:49], v[60:61] neg_lo:[0,1] neg_hi:[0,1]
    v_cvt_pk_bf16_f32 v64, v64, v65
    v_and_b32 v65, 0xffff0000, v64
    v_lshlrev_b32 v64, 16, v64
    v_pk_mul_f32 v[64:65], v[64:65], v[62:63]
    v_cvt_pk_bf16_f32 v24, v64, v65
    v_pk_add_f32 v[64:65], v[50:51], v[60:61] neg_lo:[0,1] neg_hi:[0,1]
    v_cvt_pk_bf16_f32 v64, v64, v65
    v_and_b32 v65, 0xffff0000, v64
    v_lshlrev_b32 v64, 16, v64
    v_pk_mul_f32 v[64:65], v[64:65], v[62:63]
    v_cvt_pk_bf16_f32 v25, v64, v65
    v_pk_add_f32 v[64:65], v[52:53], v[60:61] neg_lo:[0,1] neg_hi:[0,1]
    v_cvt_pk_bf16_f32 v64, v64, v65
    v_and_b32 v65, 0xffff0000, v64
    v_lshlrev_b32 v64, 16, v64
    v_pk_mul_f32 v[64:65], v[64:65], v[62:63]
    v_cvt_pk_bf16_f32 v26, v64, v65
    v_pk_add_f32 v[64:65], v[54:55], v[60:61] neg_lo:[0,1] neg_hi:[0,1]
    v_cvt_pk_bf16_f32 v64, v64, v65
    v_and_b32 v65, 0xffff0000, v64
    v_lshlrev_b32 v64, 16, v64
    v_pk_mul_f32 v[64:65], v[64:65], v[62:63]
    v_cvt_pk_bf16_f32 v27, v64, v65
    v_pk_add_f32 v[64:65], v[56:57], v[60:61] neg_lo:[0,1] neg_hi:[0,1]
    v_cvt_pk_bf16_f32 v64, v64, v65
    v_and_b32 v65, 0xffff0000, v64
    v_lshlrev_b32 v64, 16, v64
    v_pk_mul_f32 v[64:65], v[64:65], v[62:63]
    v_cvt_pk_bf16_f32 v28, v64, v65
    v_pk_add_f32 v[64:65], v[58:59], v[60:61] neg_lo:[0,1] neg_hi:[0,1]
    v_cvt_pk_bf16_f32 v64, v64, v65
    v_and_b32 v65, 0xffff0000, v64
    v_lshlrev_b32 v64, 16, v64
    v_pk_mul_f32 v[64:65], v[64:65], v[62:63]
    v_cvt_pk_bf16_f32 v29, v64, v65
    ds_write_b64 v9, v[16:17] offset:0
    ds_write_b64 v9, v[18:19] offset:128
    ds_write_b64 v9, v[20:21] offset:256
    ds_write_b64 v9, v[22:23] offset:384
    ds_write_b64 v9, v[24:25] offset:512
    ds_write_b64 v9, v[26:27] offset:640
    ds_write_b64 v9, v[28:29] offset:768
    s_waitcnt lgkmcnt(0)
    v_mov_b32 v2, 1
    ds_write_b32 v1, v2 offset:0
L_noln:
    s_cmp_eq_u32 s60, 1
    s_cbranch_scc1 L_tb2
    s_mov_b32 s12, 0x40000
L_lw_35:
    ds_read_b32 v2, v1 offset:8
    s_waitcnt lgkmcnt(0)
    v_cmp_le_i32 vcc, 5, v2
    s_cbranch_vccnz L_lwd_36
    s_sleep 2
    s_sub_u32 s12, s12, 1
    s_cbranch_scc0 L_lw_35
L_lwd_36:
L_tb2:
    s_add_u32 s4, s38, s58
    s_addc_u32 s5, s39, 0
    s_mov_b32 s10, 0
    s_load_dwordx16 s[16:31], s[4:5], 0
    s_load_dwordx16 s[84:99], s[4:5], 64
    s_waitcnt lgkmcnt(0)
    s_cmp_eq_u64 s[16:17], s[8:9]
    s_cbranch_scc0 L_mixed
    s_cmp_eq_u64 s[18:19], s[8:9]
    s_cbranch_scc0 L_mixed
    s_cmp_eq_u64 s[20:21], s[8:9]
    s_cbranch_scc0 L_mixed
    s_cmp_eq_u64 s[22:23], s[8:9]
    s_cbranch_scc0 L_mixed
    s_cmp_eq_u64 s[24:25], s[8:9]
    s_cbranch_scc0 L_mixed
    s_cmp_eq_u64 s[26:27], s[8:9]
    s_cbranch_scc0 L_mixed
    s_cmp_eq_u64 s[28:29], s[8:9]
    s_cbranch_scc0 L_mixed
    s_cmp_eq_u64 s[30:31], s[8:9]
    s_cbranch_scc0 L_mixed
    s_cmp_eq_u64 s[84:85], s[8:9]
    s_cbranch_scc0 L_mixed
    s_cmp_eq_u64 s[86:87], s[8:9]
    s_cbranch_scc0 L_mixed
    s_cmp_eq_u64 s[88:89], s[8:9]
    s_cbranch_scc0 L_mixed
    s_cmp_eq_u64 s[90:91], s[8:9]
    s_cbranch_scc0 L_mixed
    s_cmp_eq_u64 s[92:93], s[8:9]
    s_cbranch_scc0 L_mixed
    s_cmp_eq_u64 s[94:95], s[8:9]
    s_cbranch_scc0 L_mixed
    s_cmp_eq_u64 s[96:97], s[8:9]
    s_cbranch_scc0 L_mixed
    s_cmp_eq_u64 s[98:99], s[8:9]
    s_cbranch_scc0 L_mixed
    s_mov_b32 s10, 1
L_mixed:
    s_mov_b32 s68, s10
    v_mov_b32 v2, s10
    ds_write_b32 v1, v2 offset:28
    s_add_u32 s4, s38, 156672
    s_addc_u32 s5, s39, 0
    s_load_dwordx2 s[16:17], s[4:5], 0
    s_load_dwordx2 s[18:19], s[4:5], 128
    s_load_dwordx2 s[20:21], s[4:5], 256
    s_load_dwordx2 s[22:23], s[4:5], 384
    s_load_dwordx2 s[24:25], s[4:5], 512
    s_load_dwordx2 s[26:27], s[4:5], 640
    s_load_dwordx2 s[28:29], s[4:5], 768
    s_load_dwordx2 s[30:31], s[4:5], 896
    s_mov_b32 s6, 0
    s_waitcnt lgkmcnt(0)
    s_sub_u32 s7, s16, s70
    s_cmp_eq_u32 s17, s15
    s_cselect_b32 s7, s7, 0
    s_add_u32 s6, s6, s7
    s_sub_u32 s7, s18, s70
    s_cmp_eq_u32 s19, s15
    s_cselect_b32 s7, s7, 0
    s_add_u32 s6, s6, s7
    s_sub_u32 s7, s20, s70
    s_cmp_eq_u32 s21, s15
    s_cselect_b32 s7, s7, 0
    s_add_u32 s6, s6, s7
    s_sub_u32 s7, s22, s70
    s_cmp_eq_u32 s23, s15
    s_cselect_b32 s7, s7, 0
    s_add_u32 s6, s6, s7
    s_sub_u32 s7, s24, s70
    s_cmp_eq_u32 s25, s15
    s_cselect_b32 s7, s7, 0
    s_add_u32 s6, s6, s7
    s_sub_u32 s7, s26, s70
    s_cmp_eq_u32 s27, s15
    s_cselect_b32 s7, s7, 0
    s_add_u32 s6, s6, s7
    s_sub_u32 s7, s28, s70
    s_cmp_eq_u32 s29, s15
    s_cselect_b32 s7, s7, 0
    s_add_u32 s6, s6, s7
    s_sub_u32 s7, s30, s70
    s_cmp_eq_u32 s31, s15
    s_cselect_b32 s7, s7, 0
    s_add_u32 s6, s6, s7
    s_ashr_i32 s6, s6, 3
    s_min_i32 s6, s6, 300
    s_max_i32 s6, s6, -300
    v_mov_b32 v2, s6
    ds_write_b32 v1, v2 offset:32
    s_sub_u32 s59, s2, 128
    s_and_b32 s45, s59, 3
    s_lshr_b32 s46, s59, 2
    s_mul_i32 s47, s45, 28
    s_and_b32 s66, s46, -4
    s_add_u32 s47, s47, s66
    s_and_b32 s66, s46, 1
    s_lshl1_add_u32 s47, s66, s47
    s_bfe_u32 s66, s46, 0x10001
    s_add_u32 s47, s47, s66
    s_lshl_b32 s66, s47, 12
    s_mul_i32 s45, s45, 896
    s_lshr_b32 s47, s46, 2
    s_lshl_b32 s47, s47, 7
    s_add_u32 s45, s45, s47
    s_and_b32 s46, s46, 3
    s_lshl_b32 s46, s46, 3
    s_add_u32 s63, s45, s46
    v_and_b32 v12, 1, v5
    v_lshlrev_b32 v12, 6, v12
    v_lshrrev_b32 v13, 1, v5
    v_lshl_add_u32 v12, v13, 5, v12
    v_lshl_add_u32 v12, v8, 1, v12
    s_mul_i32 s45, s42, 30720
    s_lshl_b32 s46, s40, 11
    s_add_u32 s45, s45, s46
    s_add_u32 s45, s45, 4096
    v_lshlrev_b32 v9, 4, v0
    v_lshlrev_b32 v10, 3, v0
    v_add_u32 v11, 134720, v10
    s_add_u32 s47, s45, 258048
    v_mul_u32_u24 v14, 30720, v5
    v_lshl_add_u32 v14, v6, 4, v14
    s_lshl_b32 s5, s61, 8
    s_add_u32 s5, s5, 20480
    s_sub_u32 s5, s5, s45
    v_mul_u32_u24 v15, 144, v5
    v_lshrrev_b32 v30, 3, v6
    v_lshl_add_u32 v15, v30, 6, v15
    v_lshl_add_u32 v15, v8, 4, v15
    v_bfe_u32 v30, v6, 2, 1
    v_lshl_add_u32 v15, v30, 3, v15
    v_add_u32 v15, 136896, v15
    s_mov_b32 s12, 0x40000
L_lw_37:
    ds_read_b32 v2, v1 offset:8
    s_waitcnt lgkmcnt(0)
    v_cmp_le_i32 vcc, 9, v2
    s_cbranch_vccnz L_lwd_38
    s_sleep 2
    s_sub_u32 s12, s12, 1
    s_cbranch_scc0 L_lw_37
L_lwd_38:
    s_xor_b32 s7, s45, s47
    s_cmp_eq_u32 s68, 0
    s_cselect_b32 s7, s7, 0
    s_cmp_eq_u32 s60, 3
    s_cselect_b32 s13, 3, 1
    s_mov_b32 s12, 0x4000
    s_mov_b32 s4, s47
    v_lshlrev_b32 v25, 2, v0
L_qpoll:
    s_cmp_eq_u32 s68, 0
    s_cbranch_scc0 L_qload
    s_mov_b32 exec_hi, 0
    buffer_load_dword v24, v25, s[48:51], s58 offen sc1
    s_mov_b32 exec_hi, -1
L_qload:
    s_bitcmp1_b32 s13, 0
    s_cbranch_scc0 L_hload
    buffer_load_dwordx4 v[16:19], v9, s[48:51], s47 offen sc1
    buffer_load_dwordx4 v[20:23], v9, s[48:51], s47 offen offset:1024 sc1
L_hload:
    s_bitcmp1_b32 s13, 1
    s_cbranch_scc0 L_loaded
    s_add_u32 s6, s47, s5
    buffer_load_dwordx4 v[32:35], v14, s[48:51], s6 offen sc1
    s_add_u32 s6, s6, 7168
    buffer_load_dwordx4 v[36:39], v14, s[48:51], s6 offen sc1
L_loaded:
    s_xor_b32 s47, s47, s7
    s_waitcnt vmcnt(0)
    s_cmp_eq_u32 s68, 0
    s_cbranch_scc0 L_qchk
    v_cmp_ne_u32 vcc, s8, v24
    s_cmp_eq_u32 vcc_lo, 0
    s_cbranch_scc0 L_qchk
    s_mov_b32 s68, 1
    s_mov_b32 s7, 0
    s_mov_b32 s47, s4
    v_mov_b32 v2, s68
    ds_write_b32 v1, v2 offset:28
L_qchk:
    s_bitcmp1_b32 s13, 0
    s_cbranch_scc0 L_hchk
    v_cmp_ne_u32 vcc, s15, v17
    v_cmp_ne_u32 s[10:11], s15, v19
    s_or_b64 vcc, vcc, s[10:11]
    v_cmp_ne_u32 s[10:11], s15, v21
    s_or_b64 vcc, vcc, s[10:11]
    v_cmp_ne_u32 s[10:11], s15, v23
    s_or_b64 vcc, vcc, s[10:11]
    s_cbranch_scc1 L_hchk
    s_and_b32 s13, s13, 2
    ds_write2_b32 v11, v16, v18 offset0:0 offset1:1
    ds_write2_b32 v11, v20, v22 offset0:136 offset1:137
    s_waitcnt lgkmcnt(0)
    v_mov_b32 v2, 1
    ds_write_b32 v1, v2 offset:4
L_hchk:
    s_bitcmp1_b32 s13, 1
    s_cbranch_scc0 L_chkd
    v_cmp_ne_u32 vcc, s15, v33
    v_cmp_ne_u32 s[10:11], s15, v35
    s_or_b64 vcc, vcc, s[10:11]
    v_cmp_ne_u32 s[10:11], s15, v37
    s_or_b64 vcc, vcc, s[10:11]
    v_cmp_ne_u32 s[10:11], s15, v39
    s_or_b64 vcc, vcc, s[10:11]
    s_cbranch_scc1 L_chkd
    s_and_b32 s13, s13, 1
    v_lshlrev_b32 v40, 16, v32
    v_and_b32 v41, 0xffff0000, v32
    v_lshlrev_b32 v42, 16, v36
    v_and_b32 v43, 0xffff0000, v36
    v_max_f32 v40, 0, v40
    v_max_f32 v41, 0, v41
    v_mul_f32 v40, v40, v42
    v_mul_f32 v41, v41, v43
    v_cvt_pk_bf16_f32 v28, v40, v41
    v_lshlrev_b32 v40, 16, v34
    v_and_b32 v41, 0xffff0000, v34
    v_lshlrev_b32 v42, 16, v38
    v_and_b32 v43, 0xffff0000, v38
    v_max_f32 v40, 0, v40
    v_max_f32 v41, 0, v41
    v_mul_f32 v40, v40, v42
    v_mul_f32 v41, v41, v43
    v_cvt_pk_bf16_f32 v29, v40, v41
    ds_write_b64 v15, v[28:29]
    s_waitcnt lgkmcnt(0)
    v_mov_b32 v2, 8
    ds_write_b32 v1, v2 offset:24
L_chkd:
    s_cmp_eq_u32 s13, 0
    s_cbranch_scc1 L_gathered
    s_sleep 4
    s_sub_u32 s12, s12, 1
    s_cbranch_scc0 L_qpoll
L_gathered:
    s_cmp_ge_u32 s41, 28
    s_cbranch_scc0 L_nowarm2
    s_lshl_b32 s46, s40, 16
    s_sub_u32 s47, s41, 28
    s_lshl_b32 s47, s47, 14
    s_add_u32 s46, s46, s47
    s_add_u32 s46, s46, 1048576
    v_lshlrev_b32 v14, 7, v0
    buffer_load_dword v15, v14, s[48:51], s46 offen sc1
    s_add_u32 s46, s46, 8192
    buffer_load_dword v15, v14, s[48:51], s46 offen sc1
    s_add_u32 s46, s46, 8192
L_nowarm2:
    s_cmp_lt_u32 s2, 8
    s_cbranch_scc0 L_noagg
    s_lshl_b32 s46, s40, 7
    s_mul_i32 s47, s40, 4096
    s_add_u32 s47, s47, 3145728
    s_add_u32 s46, s46, 159744
    v_and_b32 v14, 31, v0
    v_lshlrev_b32 v14, 2, v14
    v_mul_u32_u24 v15, 128, v0
    v_mov_b32 v17, s15
    s_mov_b32 s12, 0x40000
L_lw_39:
    ds_read_b32 v2, v1 offset:8
    s_waitcnt lgkmcnt(0)
    v_cmp_le_i32 vcc, 40, v2
    s_cbranch_vccnz L_lwd_40
    s_sleep 2
    s_sub_u32 s12, s12, 1
    s_cbranch_scc0 L_lw_39
L_lwd_40:
    s_mov_b32 s12, 0x4000
L_agg:
    buffer_load_dword v16, v14, s[48:51], s46 offen sc1
    s_waitcnt vmcnt(0)
    v_cmp_ne_u32 vcc, s15, v16
    s_cbranch_vccz L_aggok
    s_sub_u32 s12, s12, 1
    s_cbranch_scc0 L_agg
L_aggok:
    s_mov_b64 exec, 0xff
    buffer_store_dword v17, v15, s[48:51], s47 offen sc1
    s_mov_b64 exec, -1
L_noagg:
    s_cmp_lt_u32 s59, 112
    s_cbranch_scc0 L_hdone
    buffer_load_ushort v13, v12, s[52:55], s63 offen
    s_add_u32 s46, s66, 2621440
    s_add_u32 s45, s66, 2097152
    s_movk_i32 s8, 0xff
    s_and_b32 s4, s15, s8
    s_bfe_u32 s5, s15, 0x80008
    s_bfe_u32 s6, s15, 0x80010
    s_lshr_b32 s7, s15, 24
    v_mov_b32 v20, s4
    v_mov_b32 v21, s5
    v_mov_b32 v22, s6
    v_mov_b32 v23, s7
    s_add_u32 s47, s64, 30
    s_mov_b32 s52, s34
    s_mov_b32 s53, s35
    s_mov_b32 s54, 3584
    s_mov_b32 s55, 0x20000
    s_mov_b32 s12, 0x40000
L_lw_41:
    ds_read_b32 v2, v1 offset:8
    s_waitcnt lgkmcnt(0)
    v_cmp_le_i32 vcc, s47, v2
    s_cbranch_vccnz L_lwd_42
    s_sleep 2
    s_sub_u32 s12, s12, 1
    s_cbranch_scc0 L_lw_41
L_lwd_42:
    s_waitcnt vmcnt(0)
    v_lshlrev_b32 v13, 16, v13
    s_and_b32 s47, s65, 7
    s_mul_i32 s47, s47, 128
    s_add_u32 s47, s47, 3145728
    s_mov_b32 s12, 0x4000
    v_mul_u32_u24 v14, 4096, v0
    s_mov_b64 exec, 0xff
L_hint:
    buffer_load_dword v15, v14, s[48:51], s47 offen sc1
    s_waitcnt vmcnt(0)
    v_cmp_ne_u32 vcc, s15, v15
    s_cbranch_vccz L_hintok
    s_sub_u32 s12, s12, 1
    s_cbranch_scc0 L_hint
L_hintok:
    s_mov_b64 exec, -1
    s_mov_b32 s12, 0x4000
L_final:
    buffer_load_dwordx4 v[16:19], v9, s[48:51], s46 offen sc1
    s_mov_b32 exec_hi, 0xffff
    buffer_load_dwordx4 v[20:23], v9, s[48:51], s46 offen offset:1024 sc1
    s_mov_b32 exec_hi, -1
    buffer_load_dwordx4 v[24:27], v9, s[48:51], s45 offen offset:0 sc1
    buffer_load_dwordx4 v[28:31], v9, s[48:51], s45 offen offset:1024 sc1
    buffer_load_dwordx4 v[32:35], v9, s[48:51], s45 offen offset:2048 sc1
    buffer_load_dwordx4 v[36:39], v9, s[48:51], s45 offen offset:3072 sc1
    s_waitcnt vmcnt(4)
    v_xor_b32 v16, s4, v16
    v_xor_b32 v17, s5, v17
    v_xor_b32 v18, s6, v18
    v_xor_b32 v19, s7, v19
    v_xor_b32 v48, s4, v20
    v_xor_b32 v49, s5, v21
    v_xor_b32 v50, s6, v22
    v_xor_b32 v51, s7, v23
    v_or3_b32 v44, v16, v17, v18
    v_or3_b32 v44, v44, v19, v48
    v_or3_b32 v44, v44, v49, v50
    v_bitop3_b32 v44, v44, v51, s8 bitop3:0xa8
    v_pk_add_f32 v[16:17], v[16:17], v[48:49]
    v_pk_add_f32 v[18:19], v[18:19], v[50:51]
    v_cmp_ne_u32 s[16:17], 0, v44
    v_permlane32_swap_b32 v16, v17
    v_permlane32_swap_b32 v18, v19
    v_add_f32 v16, v16, v17
    v_add_f32 v18, v18, v19
    s_nop 1
    v_permlane16_swap_b32 v16, v18
    v_add_f32 v16, v16, v18
    s_nop 1
    v_add_f32_dpp v16, v16, v16 row_ror:4 row_mask:0xf bank_mask:0xf
    s_nop 1
    v_add_f32_dpp v16, v16, v16 row_ror:8 row_mask:0xf bank_mask:0xf
    v_cvt_pk_bf16_f32 v16, v16, v16
    v_and_b32 v16, 0xffff0000, v16
    v_mul_f32 v46, 0xbfb8aa3b, v16
    v_exp_f32 v46, v46
    s_nop 0
    v_add_f32 v46, 1.0, v46
    v_rcp_f32 v46, v46
    s_nop 0
    v_mul_f32 v16, v16, v46
    v_cvt_pk_bf16_f32 v16, v16, v16
    v_and_b32 v16, 0xffff0000, v16
    s_waitcnt vmcnt(0)
    v_xor_b32 v24, s4, v24
    v_xor_b32 v25, s5, v25
    v_xor_b32 v26, s6, v26
    v_xor_b32 v27, s7, v27
    v_xor_b32 v28, s4, v28
    v_xor_b32 v29, s5, v29
    v_xor_b32 v30, s6, v30
    v_xor_b32 v31, s7, v31
    v_xor_b32 v32, s4, v32
    v_xor_b32 v33, s5, v33
    v_xor_b32 v34, s6, v34
    v_xor_b32 v35, s7, v35
    v_xor_b32 v36, s4, v36
    v_xor_b32 v37, s5, v37
    v_xor_b32 v38, s6, v38
    v_xor_b32 v39, s7, v39
    v_or3_b32 v40, v24, v25, v26
    v_or3_b32 v40, v40, v27, v28
    v_or3_b32 v40, v40, v29, v30
    v_or3_b32 v40, v40, v31, v32
    v_or3_b32 v40, v40, v33, v34
    v_or3_b32 v40, v40, v35, v36
    v_or3_b32 v40, v40, v37, v38
    v_bitop3_b32 v40, v40, v39, s8 bitop3:0xa8
    v_cmp_ne_u32 vcc, 0, v40
    s_or_b64 s[10:11], vcc, s[16:17]
    s_cbranch_scc1 L_fretry
L_finalok:
    v_pk_add_f32 v[24:25], v[24:25], v[28:29]
    v_pk_add_f32 v[32:33], v[32:33], v[36:37]
    v_pk_add_f32 v[26:27], v[26:27], v[30:31]
    v_pk_add_f32 v[34:35], v[34:35], v[38:39]
    v_pk_add_f32 v[24:25], v[24:25], v[32:33]
    v_pk_add_f32 v[26:27], v[26:27], v[34:35]
    s_nop 0
    v_permlane32_swap_b32 v24, v25
    v_permlane32_swap_b32 v26, v27
    v_add_f32 v24, v24, v25
    v_add_f32 v26, v26, v27
    s_nop 1
    v_permlane16_swap_b32 v24, v26
    v_add_f32 v24, v24, v26
    s_nop 1
    v_add_f32_dpp v24, v24, v24 row_ror:4 row_mask:0xf bank_mask:0xf
    s_nop 1
    v_add_f32_dpp v24, v24, v24 row_ror:8 row_mask:0xf bank_mask:0xf
    v_cvt_pk_bf16_f32 v24, v24, v24
    v_and_b32 v24, 0xffff0000, v24
    v_mul_f32 v24, v24, v16
    v_cvt_pk_bf16_f32 v24, v24, v24
    v_and_b32 v24, 0xffff0000, v24
    v_add_f32 v24, v24, v13
    v_cvt_pk_bf16_f32 v24, v24, v24
    s_mov_b32 exec_lo, 0x000f000f
    s_mov_b32 exec_hi, 0x000f000f
    buffer_store_short v24, v12, s[52:55], s63 offen
    s_cmp_lg_u32 s59, 0
    s_cbranch_scc1 L_hdone
    s_mov_b64 exec, 1
    v_mov_b32 v2, s15
    v_mov_b32 v3, 0
    buffer_store_dword v2, v3, s[48:51], 0 offen offset:0
L_hdone:
    s_endpgm
L_fretry:
    s_sub_u32 s12, s12, 1
    s_cbranch_scc1 L_fdone
    s_cmp_lg_u64 s[16:17], 0
    s_cbranch_scc1 L_final
    s_mov_b64 exec, vcc
    buffer_load_dwordx4 v[24:27], v9, s[48:51], s45 offen offset:0 sc1
    buffer_load_dwordx4 v[28:31], v9, s[48:51], s45 offen offset:1024 sc1
    buffer_load_dwordx4 v[32:35], v9, s[48:51], s45 offen offset:2048 sc1
    buffer_load_dwordx4 v[36:39], v9, s[48:51], s45 offen offset:3072 sc1
    s_waitcnt vmcnt(0)
    v_xor_b32 v24, s4, v24
    v_xor_b32 v25, s5, v25
    v_xor_b32 v26, s6, v26
    v_xor_b32 v27, s7, v27
    v_xor_b32 v28, s4, v28
    v_xor_b32 v29, s5, v29
    v_xor_b32 v30, s6, v30
    v_xor_b32 v31, s7, v31
    v_xor_b32 v32, s4, v32
    v_xor_b32 v33, s5, v33
    v_xor_b32 v34, s6, v34
    v_xor_b32 v35, s7, v35
    v_xor_b32 v36, s4, v36
    v_xor_b32 v37, s5, v37
    v_xor_b32 v38, s6, v38
    v_xor_b32 v39, s7, v39
    v_or3_b32 v40, v24, v25, v26
    v_or3_b32 v40, v40, v27, v28
    v_or3_b32 v40, v40, v29, v30
    v_or3_b32 v40, v40, v31, v32
    v_or3_b32 v40, v40, v33, v34
    v_or3_b32 v40, v40, v35, v36
    v_or3_b32 v40, v40, v37, v38
    v_bitop3_b32 v40, v40, v39, s8 bitop3:0xa8
    v_cmp_ne_u32 vcc, 0, v40
    s_cbranch_vccnz L_fretry
L_fdone:
    s_mov_b64 exec, -1
    s_branch L_finalok
L_exit:
    s_endpgm
L_codeend:
.section .rodata,"a"
.p2align 6
.amdhsa_kernel recurrent_scan__sliding_block_cached__glu_gated_reglu__decode_kernel
  .amdhsa_next_free_vgpr 152
  .amdhsa_next_free_sgpr 100
  .amdhsa_accum_offset 152
  .amdhsa_group_segment_fixed_size 0
  .amdhsa_kernarg_size 96
  .amdhsa_user_sgpr_count 2
  .amdhsa_user_sgpr_kernarg_segment_ptr 1
  .amdhsa_system_sgpr_workgroup_id_x 1
  .amdhsa_float_denorm_mode_32 3
.end_amdhsa_kernel
```
